```python
import torch

def _softmax(x, axis=-1):
    return torch.softmax(x, dim=axis)
def _gelu(x):
    return torch.nn.functional.gelu(x, approximate="tanh")
def _silu(x):
    return torch.nn.functional.silu(x)
def _sigmoid(x):
    return torch.sigmoid(x)
def _layernorm(x, axis=-1, eps=1e-5):
    m = x.mean(dim=axis, keepdim=True)
    v = x.var(dim=axis, keepdim=True, unbiased=False)
    return (x - m) / torch.sqrt(v + eps)
def _scatter_add(tgt, idx, src, axis=0):
    return tgt.clone().index_add_(axis, idx, src)
def _segment_sum(src, seg, n):
    out = torch.zeros((n,) + src.shape[1:], dtype=src.dtype)
    return out.index_add_(0, seg, src)
def _pad(x, pw):
    flat = tuple(v for pair in reversed(pw) for v in pair)
    return torch.nn.functional.pad(x, flat)

kernel_name = 'standalone__cross_network_dcn__recsys'

def setup_inputs():

    _w = (lambda a: (lambda t: t.to(torch.bfloat16) if t.is_floating_point() else t)(torch.as_tensor(a)))
    B, F, D, L = 1024, 26, 32, 6
    Din = min(F * D, 1024)
    return {
        "x0": _w((lambda *s: torch.randn(*s, dtype=torch.bfloat16) * 0.05)(B, Din)),
        "ws": _w((lambda *s: torch.randn(*s, dtype=torch.bfloat16) * 0.8)(L, Din, Din) * (Din ** -0.5)),
        "bs": _w((lambda *s: torch.randn(*s, dtype=torch.bfloat16) * 3.2)(L, Din) * 0.01),
    }

def reference(x0, ws, bs):
    x = x0
    L = ws.shape[0]
    for l in range(L):
        proj = torch.einsum('bd,de->be', x, ws[l]) + bs[l]
        x = x0 * proj + x
    return x
```

```asm
; @launch grid=(256,1,1) block=(256,1,1) lds=163840
.amdgcn_target "amdgcn-amd-amdhsa--gfx950"
.text
.globl standalone__cross_network_dcn__recsys_kernel
.p2align 8
.type standalone__cross_network_dcn__recsys_kernel,@function
standalone__cross_network_dcn__recsys_kernel:
    s_cmp_ge_u32 s2, 256
    s_cbranch_scc1 L_EXIT
    s_load_dwordx2 s[20:21], s[0:1], 8
    s_load_dwordx2 s[16:17], s[0:1], 0
    s_load_dwordx2 s[24:25], s[0:1], 16
    s_load_dwordx2 s[36:37], s[0:1], 40
    s_load_dwordx2 s[28:29], s[0:1], 24
    s_load_dwordx2 s[32:33], s[0:1], 32
    v_readfirstlane_b32 s42, v0
    s_lshr_b32 s3, s2, 3
    s_and_b32 s15, s2, 7
    v_and_b32 v0, 63, v0
    s_mov_b32 s22, 8306688
    s_mov_b32 s23, 0x00020000
    s_lshr_b32 s42, s42, 6
    s_cmp_ge_u32 s3, 26
    s_cbranch_scc1 L_HELP
    s_lshl_b32 s40, s15, 1
    s_cmp_ge_u32 s3, 13
    s_cselect_b32 s41, 13, 0
    s_cselect_b32 s53, -1, 0
    s_cselect_b32 s56, 0x333, 0
    s_cselect_b32 s57, 0, 0x333000
    s_addc_u32 s40, s40, 0
    s_sub_u32 s41, s3, s41
    s_and_b32 s51, s42, 1
    s_lshr_b32 s52, s42, 1
    s_lshl_b32 s54, s15, 2
    s_or_b32 s54, s54, 0x40000
    s_bfe_u32 s54, 0x40840840, s54
    s_or_b32 s54, s54, 0xc0000
    s_bfe_u32 s54, 0x10210, s54
    s_mul_i32 s54, s54, 0x1001
    s_add_u32 s54, s54, s56
    s_add_u32 s54, s54, s57
    v_and_b32 v1, 14, v0
    v_lshlrev_b32 v1, 1, v1
    v_bfe_u32 v1, s54, v1, 4
    s_mul_i32 s55, s51, 6
    s_add_u32 s55, s55, s41
    v_add3_u32 v1, v1, s55, 1
    v_subrev_u32 v2, 13, v1
    v_min_u32 v1, v1, v2
    v_and_b32 v2, 1, v0
    v_lshl_or_b32 v2, v1, 1, v2
    v_mul_u32_u24 v63, 53248, v2
    v_lshlrev_b32 v62, 7, v1
    v_lshrrev_b32 v2, 3, v0
    v_and_b32 v3, 7, v0
    s_lshl_b32 s55, s40, 1
    s_add_u32 s55, s55, s52
    s_mul_i32 s56, s55, 53248
    v_mul_u32_u24 v4, 1664, v2
    v_lshrrev_b32 v8, 4, v0
    v_xor_b32 v8, v8, v3
    v_lshlrev_b32 v8, 4, v8
    v_xor_b32 v9, 64, v8
    v_add3_u32 v8, v8, v4, s56
    s_add_u32 s56, s56, 12288
    v_add3_u32 v9, v9, v4, s56
    s_lshl_b32 s57, s41, 7
    s_mul_i32 s54, s52, 26624
    s_add_u32 s54, s54, s57
    v_and_b32 v6, 2, v2
    v_lshlrev_b32 v6, 1, v6
    v_xor_b32 v6, v6, v3
    v_lshl_add_u32 v6, v6, 4, s54
    v_add_u32 v4, v4, v6
    v_and_b32 v7, 4, v2
    v_mul_u32_u24 v7, 1664, v7
    v_add_u32 v6, v4, v7
    v_add_u32 v7, 5632, v6
    s_mul_i32 s54, s51, 26624
    s_add_u32 s54, s54, s57
    s_lshl_b32 s83, s41, 1
    s_add_u32 s83, s83, s51
    s_lshl_b32 s56, s83, 6
    s_mul_i32 s83, s83, 53248
    v_and_b32 v1, 32, v0
    v_lshlrev_b32 v1, 20, v1
    v_lshl_add_u32 v1, v0, 1, v1
    s_lshl_b32 s46, s51, 1
    s_add_u32 s46, s46, s52
    s_lshl_b32 s46, s46, 11
    s_mov_b32 s18, 1703936
    s_mov_b32 s19, 0x00020000
    s_mov_b32 s26, 9984
    s_mov_b32 s27, 0x00020000
    v_readlane_b32 s71, v63, 0
    v_readlane_b32 s72, v63, 1
    s_lshl_b32 s47, s42, 11
    s_add_u32 m0, s47, 155648
    s_add_u32 s50, s56, 4992
    s_mov_b32 s34, 256
    s_mov_b32 s35, 0x00020000
    s_getreg_b32 s49, hwreg(HW_REG_XCC_ID)
    s_and_b32 s49, s49, 15
    s_or_b32 s49, s49, 0x80
    s_lshl_b32 s47, s42, 4
    s_add_u32 s47, s47, s40
    s_lshl_b32 s47, s47, 4
    s_add_u32 s47, s47, s41
    v_lshl_add_u32 v250, v0, 8, s47
    v_mov_b32 v251, s49
    s_waitcnt lgkmcnt(0)
    buffer_store_byte v251, v250, s[32:35], 0 offen sc1
    buffer_load_dwordx4 v8, s[16:19], s54 offen lds
    buffer_load_dwordx4 v9, s[16:19], s54 offen offset:1024 lds
    s_mov_b32 m0, s46
    buffer_load_ushort v48, v1, s[24:27], s56 offen offset:0
    buffer_load_ushort v56, v1, s[24:27], s56 offen offset:1664
    buffer_load_ushort v57, v1, s[24:27], s56 offen offset:3328
    buffer_load_ushort v58, v1, s[24:27], s50 offen offset:0
    buffer_load_ushort v59, v1, s[24:27], s50 offen offset:1664
    buffer_load_ushort v60, v1, s[24:27], s50 offen offset:3328
    buffer_load_dwordx4 v6, s[20:23], s83 offen lds
    buffer_load_dwordx4 v7, s[20:23], s83 offen offset:1024 lds
    s_add_u32 m0, s46, 8192
    v_readlane_b32 s73, v63, 2
    buffer_load_dwordx4 v6, s[20:23], s71 offen lds
    buffer_load_dwordx4 v7, s[20:23], s71 offen offset:1024 lds
    s_mov_b32 s38, 8519680
    s_mov_b32 s39, 0x00020000
    s_mul_i32 s54, s40, 106496
    v_lshl_add_u32 v28, v0, 4, s54
    v_mov_b32 v24, -1
    v_mov_b32 v25, -1
    v_mov_b32 v26, -1
    v_mov_b32 v27, -1
    s_lshl_b32 s48, s41, 11
    s_add_u32 m0, s46, 16384
    v_readlane_b32 s74, v63, 3
    buffer_load_dwordx4 v6, s[20:23], s72 offen lds
    buffer_load_dwordx4 v7, s[20:23], s72 offen offset:1024 lds
    v_readlane_b32 s75, v63, 4
    v_readlane_b32 s76, v63, 5
    v_readlane_b32 s77, v63, 6
    v_readlane_b32 s78, v63, 7
    v_readlane_b32 s4, v62, 0
    v_readlane_b32 s5, v62, 2
    v_readlane_b32 s6, v62, 4
    v_readlane_b32 s7, v62, 6
    v_readlane_b32 s8, v62, 8
    v_readlane_b32 s9, v62, 10
    s_mov_b32 s30, 1703936
    s_mov_b32 s31, 0x00020000
    s_mov_b32 s34, 256
    s_mov_b32 s35, 0x00020000
    s_mul_i32 s54, s42, 26624
    v_add_u32 v28, s54, v28
    s_add_u32 s50, s48, 3407872
    v_add_u32 v10, 24576, v8
    v_add_u32 v11, 24576, v9
    v_xor_b32 v1, s53, v0
    s_and_b32 s54, s53, 14
    s_add_u32 s54, s54, s41
    v_add_u32 v1, s54, v1
    v_subrev_u32 v2, 13, v1
    v_min_u32 v1, v1, v2
    v_and_b32 v1, 15, v1
    v_lshlrev_b32 v62, 11, v1
    v_mul_u32_u24 v1, 106496, v1
    s_mul_i32 s54, s51, 53248
    s_add_u32 s54, s54, 1384448
    v_add_u32 v4, s54, v4
    v_add_u32 v5, 12288, v4
    v_readlane_b32 s58, v1, 0
    v_readlane_b32 s59, v1, 1
    v_readlane_b32 s60, v1, 2
    v_readlane_b32 s61, v1, 3
    v_readlane_b32 s62, v1, 4
    v_readlane_b32 s63, v1, 5
    v_readlane_b32 s64, v1, 6
    v_readlane_b32 s65, v1, 7
    v_readlane_b32 s66, v1, 8
    v_readlane_b32 s67, v1, 9
    v_readlane_b32 s68, v1, 10
    v_readlane_b32 s69, v1, 11
    v_readlane_b32 s70, v1, 12
    s_mov_b32 s43, 0
    s_mov_b32 s45, 20000
    s_getreg_b32 s49, hwreg(HW_REG_XCC_ID)
    s_and_b32 s49, s49, 15
    s_or_b32 s49, s49, 0x80
    s_mul_i32 s47, s42, 12288
    s_add_u32 s47, s47, 106496
    v_lshrrev_b32 v1, 5, v0
    v_bfe_u32 v2, v0, 2, 2
    v_lshl_add_u32 v2, v1, 2, v2
    s_mul_i32 s54, s51, 4160
    v_lshl_add_u32 v2, v2, 7, s54
    v_and_b32 v3, 16, v0
    v_lshl_add_u32 v2, v3, 1, v2
    v_and_b32 v3, 11, v0
    v_lshlrev_b32 v3, 3, v3
    v_xor_b32 v16, v2, v3
    v_xor_b32 v17, 64, v16
    v_add_u32 v18, 0x10000, v16
    v_add_u32 v19, 0x10000, v17
    v_and_b32 v2, 31, v0
    v_bfe_u32 v3, v0, 1, 3
    v_xor_b32 v34, v1, v3
    v_lshlrev_b32 v34, 4, v34
    v_lshl_add_u32 v34, v2, 7, v34
    s_lshl_b32 s54, s51, 6
    s_lshl_b32 s56, s52, 12
    s_add_u32 s56, s56, 155648
    v_xor_b32 v38, s54, v34
    v_add_u32 v38, s56, v38
    v_xor_b32 v39, 32, v38
    v_add_u32 v34, s47, v34
    v_xor_b32 v35, 32, v34
    v_xor_b32 v36, 64, v34
    v_xor_b32 v37, 0x60, v34
    v_mul_u32_u24 v3, 24, v1
    v_xor_b32 v40, v3, v38
    v_xor_b32 v41, 16, v40
    v_xor_b32 v42, 32, v40
    v_xor_b32 v43, 48, v40
    v_lshl_add_u32 v20, v0, 4, s47
    s_mul_i32 s56, s51, -24576
    s_add_u32 s56, s56, 12288
    v_add_u32 v21, s56, v20
    s_lshl_b32 s55, s55, 5
    v_add_u32 v2, s55, v2
    v_mul_u32_u24 v2, 1664, v2
    s_add_u32 s54, s54, s57
    v_lshl_add_u32 v30, v1, 4, s54
    v_add_u32 v30, v30, v2
    v_min_u32 v31, 15, v0
    s_lshl_b32 s54, s40, 4
    v_add_u32 v31, s54, v31
    s_add_u32 s54, s54, s41
    s_lshl_b32 s56, s42, 8
    s_add_u32 s54, s54, s56
    v_lshl_add_u32 v33, v0, 8, s54
    v_mov_b32 v32, s49
    v_mov_b32 v49, 0
    v_mov_b32 v50, 0
    v_mov_b32 v51, 0
    v_mov_b32 v52, 0x3f80
    v_mov_b32 v53, 0
    v_mov_b32 v54, 0
    v_mov_b32 v55, 0
    s_add_u32 m0, s46, 24576
    v_readlane_b32 s79, v63, 8
    buffer_load_dwordx4 v6, s[20:23], s73 offen lds
    buffer_load_dwordx4 v7, s[20:23], s73 offen offset:1024 lds
    s_add_u32 m0, s46, 32768
    v_readlane_b32 s80, v63, 9
    buffer_load_dwordx4 v6, s[20:23], s74 offen lds
    buffer_load_dwordx4 v7, s[20:23], s74 offen offset:1024 lds
    s_add_u32 m0, s46, 40960
    v_readlane_b32 s81, v63, 10
    buffer_load_dwordx4 v6, s[20:23], s75 offen lds
    buffer_load_dwordx4 v7, s[20:23], s75 offen offset:1024 lds
    s_add_u32 m0, s46, 49152
    v_readlane_b32 s82, v63, 11
    buffer_load_dwordx4 v6, s[20:23], s76 offen lds
    buffer_load_dwordx4 v7, s[20:23], s76 offen offset:1024 lds
    s_mov_b32 m0, s47
    s_nop 0
    buffer_load_dwordx4 v8, s[16:19], s4 offen lds
    buffer_load_dwordx4 v9, s[16:19], s4 offen offset:1024 lds
    buffer_load_dwordx4 v10, s[16:19], s4 offen offset:2048 lds
    buffer_load_dwordx4 v11, s[16:19], s4 offen offset:3072 lds
    s_add_u32 m0, s47, 4096
    s_nop 0
    buffer_load_dwordx4 v8, s[16:19], s5 offen lds
    buffer_load_dwordx4 v9, s[16:19], s5 offen offset:1024 lds
    buffer_load_dwordx4 v10, s[16:19], s5 offen offset:2048 lds
    buffer_load_dwordx4 v11, s[16:19], s5 offen offset:3072 lds
    s_add_u32 m0, s47, 8192
    s_nop 0
    buffer_load_dwordx4 v8, s[16:19], s6 offen lds
    buffer_load_dwordx4 v9, s[16:19], s6 offen offset:1024 lds
    buffer_load_dwordx4 v10, s[16:19], s6 offen offset:2048 lds
    buffer_load_dwordx4 v11, s[16:19], s6 offen offset:3072 lds
    s_waitcnt vmcnt(12)
    s_barrier
    ds_read_b128 v[112:115], v38
    ds_read_b128 v[116:119], v39
    ds_read_b64 v[64:65], v40
    ds_read_b64 v[66:67], v41
    ds_read_b64 v[68:69], v42
    ds_read_b64 v[70:71], v43
    v_mfma_f32_32x32x16_bf16 v[216:231], v[48:51], v[52:55], 0
    s_add_u32 m0, s46, 57344
    ds_read_b64_tr_b16 a[0:1], v16 offset:0
    ds_read_b64_tr_b16 a[2:3], v16 offset:1024
    buffer_load_dwordx4 v6, s[20:23], s77 offen lds
    ds_read_b64_tr_b16 a[4:5], v17 offset:0
    ds_read_b64_tr_b16 a[6:7], v17 offset:1024
    ds_read_b64_tr_b16 a[8:9], v16 offset:2048
    s_waitcnt vmcnt(9)
    ds_read_b128 v[120:123], v34 offset:0
    ds_read_b128 v[124:127], v35 offset:0
    ds_read_b128 v[128:131], v36 offset:0
    ds_read_b128 v[132:135], v37 offset:0
    ds_read_b64_tr_b16 a[10:11], v16 offset:3072
    ds_read_b64_tr_b16 a[12:13], v17 offset:2048
    s_waitcnt lgkmcnt(7)
    v_mfma_f32_32x32x16_bf16 v[216:231], a[0:3], v[112:115], v[216:231]
    buffer_load_dwordx4 v7, s[20:23], s77 offen offset:1024 lds
    ds_read_b64_tr_b16 a[14:15], v17 offset:3072
    ds_read_b64_tr_b16 a[16:17], v16 offset:8192
    v_mfma_f32_32x32x16_bf16 v[232:247], a[4:7], v[112:115], 0
    ds_read_b64_tr_b16 a[18:19], v16 offset:9216
    ds_read_b64_tr_b16 a[20:21], v17 offset:8192
    s_add_u32 m0, s46, 65536
    ds_read_b64_tr_b16 a[22:23], v17 offset:9216
    ds_read_b64_tr_b16 a[24:25], v16 offset:10240
    buffer_load_dwordx4 v6, s[20:23], s78 offen lds
    ds_read_b64_tr_b16 a[26:27], v16 offset:11264
    ds_read_b64_tr_b16 a[28:29], v17 offset:10240
    ds_read_b64_tr_b16 a[30:31], v17 offset:11264
    s_waitcnt lgkmcnt(8)
    v_mfma_f32_32x32x16_bf16 v[216:231], a[8:11], v[116:119], v[216:231]
    s_waitcnt vmcnt(7)
    ds_read_b128 v[136:139], v34 offset:4096
    ds_read_b128 v[140:143], v35 offset:4096
    ds_read_b128 v[144:147], v36 offset:4096
    ds_read_b128 v[148:151], v37 offset:4096
    ds_read_b64_tr_b16 a[32:33], v16 offset:16384
    ds_read_b64_tr_b16 a[34:35], v16 offset:17408
    v_mfma_f32_32x32x16_bf16 v[232:247], a[12:15], v[116:119], v[232:247]
    buffer_load_dwordx4 v7, s[20:23], s78 offen offset:1024 lds
    ds_read_b64_tr_b16 a[36:37], v17 offset:16384
    ds_read_b64_tr_b16 a[38:39], v17 offset:17408
    s_waitcnt lgkmcnt(12)
    v_mfma_f32_32x32x16_bf16 v[216:231], a[16:19], v[120:123], v[216:231]
    ds_read_b64_tr_b16 a[40:41], v16 offset:18432
    ds_read_b64_tr_b16 a[42:43], v16 offset:19456
    v_mfma_f32_32x32x16_bf16 v[232:247], a[20:23], v[120:123], v[232:247]
    s_add_u32 m0, s46, 73728
    ds_read_b64_tr_b16 a[44:45], v17 offset:18432
    ds_read_b64_tr_b16 a[46:47], v17 offset:19456
    buffer_load_dwordx4 v6, s[20:23], s79 offen lds
    ds_read_b64_tr_b16 a[48:49], v16 offset:24576
    ds_read_b64_tr_b16 a[50:51], v16 offset:25600
    ds_read_b64_tr_b16 a[52:53], v17 offset:24576
    s_waitcnt lgkmcnt(14)
    v_mfma_f32_32x32x16_bf16 v[216:231], a[24:27], v[124:127], v[216:231]
    s_waitcnt vmcnt(5)
    ds_read_b128 v[152:155], v34 offset:8192
    ds_read_b128 v[156:159], v35 offset:8192
    ds_read_b128 v[160:163], v36 offset:8192
    ds_read_b128 v[164:167], v37 offset:8192
    ds_read_b64_tr_b16 a[54:55], v17 offset:25600
    ds_read_b64_tr_b16 a[56:57], v16 offset:26624
    v_mfma_f32_32x32x16_bf16 v[232:247], a[28:31], v[124:127], v[232:247]
    buffer_load_dwordx4 v7, s[20:23], s79 offen offset:1024 lds
    ds_read_b64_tr_b16 a[58:59], v16 offset:27648
    ds_read_b64_tr_b16 a[60:61], v17 offset:26624
    s_waitcnt lgkmcnt(14)
    v_mfma_f32_32x32x16_bf16 v[216:231], a[32:35], v[128:131], v[216:231]
    ds_read_b64_tr_b16 a[62:63], v17 offset:27648
    ds_read_b64_tr_b16 a[64:65], v16 offset:32768
    v_mfma_f32_32x32x16_bf16 v[232:247], a[36:39], v[128:131], v[232:247]
    s_add_u32 m0, s46, 81920
    ds_read_b64_tr_b16 a[66:67], v16 offset:33792
    ds_read_b64_tr_b16 a[68:69], v17 offset:32768
    buffer_load_dwordx4 v6, s[20:23], s80 offen lds
    ds_read_b64_tr_b16 a[70:71], v17 offset:33792
    ds_read_b64_tr_b16 a[72:73], v16 offset:34816
    ds_read_b64_tr_b16 a[74:75], v16 offset:35840
    s_waitcnt lgkmcnt(14)
    v_mfma_f32_32x32x16_bf16 v[216:231], a[40:43], v[132:135], v[216:231]
    ds_read_b64_tr_b16 a[76:77], v17 offset:34816
    ds_read_b64_tr_b16 a[78:79], v17 offset:35840
    v_mfma_f32_32x32x16_bf16 v[232:247], a[44:47], v[132:135], v[232:247]
    buffer_load_dwordx4 v7, s[20:23], s80 offen offset:1024 lds
    ds_read_b64_tr_b16 a[80:81], v16 offset:40960
    ds_read_b64_tr_b16 a[82:83], v16 offset:41984
    s_waitcnt lgkmcnt(14)
    v_mfma_f32_32x32x16_bf16 v[216:231], a[48:51], v[136:139], v[216:231]
    ds_read_b64_tr_b16 a[84:85], v17 offset:40960
    ds_read_b64_tr_b16 a[86:87], v17 offset:41984
    v_mfma_f32_32x32x16_bf16 v[232:247], a[52:55], v[136:139], v[232:247]
    s_add_u32 m0, s46, 90112
    ds_read_b64_tr_b16 a[88:89], v16 offset:43008
    ds_read_b64_tr_b16 a[90:91], v16 offset:44032
    buffer_load_dwordx4 v6, s[20:23], s81 offen lds
    ds_read_b64_tr_b16 a[92:93], v17 offset:43008
    ds_read_b64_tr_b16 a[94:95], v17 offset:44032
    ds_read_b64_tr_b16 a[96:97], v16 offset:49152
    s_waitcnt lgkmcnt(14)
    v_mfma_f32_32x32x16_bf16 v[216:231], a[56:59], v[140:143], v[216:231]
    ds_read_b64_tr_b16 a[98:99], v16 offset:50176
    ds_read_b64_tr_b16 a[100:101], v17 offset:49152
    v_mfma_f32_32x32x16_bf16 v[232:247], a[60:63], v[140:143], v[232:247]
    buffer_load_dwordx4 v7, s[20:23], s81 offen offset:1024 lds
    ds_read_b64_tr_b16 a[102:103], v17 offset:50176
    ds_read_b64_tr_b16 a[104:105], v16 offset:51200
    s_waitcnt lgkmcnt(14)
    v_mfma_f32_32x32x16_bf16 v[216:231], a[64:67], v[144:147], v[216:231]
    ds_read_b64_tr_b16 a[106:107], v16 offset:52224
    ds_read_b64_tr_b16 a[108:109], v17 offset:51200
    v_mfma_f32_32x32x16_bf16 v[232:247], a[68:71], v[144:147], v[232:247]
    s_add_u32 m0, s46, 98304
    ds_read_b64_tr_b16 a[110:111], v17 offset:52224
    buffer_load_dwordx4 v6, s[20:23], s82 offen lds
    s_waitcnt lgkmcnt(14)
    v_mfma_f32_32x32x16_bf16 v[216:231], a[72:75], v[148:151], v[216:231]
    v_mfma_f32_32x32x16_bf16 v[232:247], a[76:79], v[148:151], v[232:247]
    buffer_load_dwordx4 v7, s[20:23], s82 offen offset:1024 lds
    s_waitcnt lgkmcnt(12)
    v_mfma_f32_32x32x16_bf16 v[216:231], a[80:83], v[152:155], v[216:231]
    v_mfma_f32_32x32x16_bf16 v[232:247], a[84:87], v[152:155], v[232:247]
    s_add_u32 s54, s48, 1703936
    buffer_store_dwordx4 v[24:27], v28, s[36:39], s54 offen sc1
    buffer_store_dwordx4 v[24:27], v28, s[36:39], s54 offen offset:1024 sc1
    s_mov_b32 m0, s47
    v_lshlrev_b32 v80, 16, v64
    buffer_load_dwordx4 v8, s[16:19], s7 offen lds
    s_waitcnt lgkmcnt(8)
    v_mfma_f32_32x32x16_bf16 v[216:231], a[88:91], v[156:159], v[216:231]
    v_and_b32 v81, 0xffff0000, v64
    v_lshlrev_b32 v82, 16, v65
    v_mfma_f32_32x32x16_bf16 v[232:247], a[92:95], v[156:159], v[232:247]
    v_and_b32 v83, 0xffff0000, v65
    buffer_load_dwordx4 v9, s[16:19], s7 offen offset:1024 lds
    s_waitcnt lgkmcnt(4)
    v_mfma_f32_32x32x16_bf16 v[216:231], a[96:99], v[160:163], v[216:231]
    v_lshlrev_b32 v84, 16, v66
    v_and_b32 v85, 0xffff0000, v66
    v_mfma_f32_32x32x16_bf16 v[232:247], a[100:103], v[160:163], v[232:247]
    v_lshlrev_b32 v86, 16, v67
    buffer_load_dwordx4 v10, s[16:19], s7 offen offset:2048 lds
    s_waitcnt lgkmcnt(0)
    v_mfma_f32_32x32x16_bf16 v[216:231], a[104:107], v[164:167], v[216:231]
    v_and_b32 v87, 0xffff0000, v67
    v_lshlrev_b32 v88, 16, v68
    v_mfma_f32_32x32x16_bf16 v[232:247], a[108:111], v[164:167], v[232:247]
    v_and_b32 v89, 0xffff0000, v68
    buffer_load_dwordx4 v11, s[16:19], s7 offen offset:3072 lds
    v_lshlrev_b32 v90, 16, v69
    v_and_b32 v91, 0xffff0000, v69
    v_lshlrev_b32 v92, 16, v70
    s_add_u32 m0, s47, 4096
    v_and_b32 v93, 0xffff0000, v70
    buffer_load_dwordx4 v8, s[16:19], s8 offen lds
    v_lshlrev_b32 v94, 16, v71
    v_and_b32 v95, 0xffff0000, v71
    v_lshlrev_b32 v96, 16, v64
    buffer_load_dwordx4 v9, s[16:19], s8 offen offset:1024 lds
    v_and_b32 v97, 0xffff0000, v64
    v_lshlrev_b32 v98, 16, v65
    v_and_b32 v99, 0xffff0000, v65
    buffer_load_dwordx4 v10, s[16:19], s8 offen offset:2048 lds
    v_lshlrev_b32 v100, 16, v66
    v_and_b32 v101, 0xffff0000, v66
    v_lshlrev_b32 v102, 16, v67
    buffer_load_dwordx4 v11, s[16:19], s8 offen offset:3072 lds
    v_and_b32 v103, 0xffff0000, v67
    v_lshlrev_b32 v104, 16, v68
    v_and_b32 v105, 0xffff0000, v68
    s_waitcnt vmcnt(10)
    s_barrier
    s_add_u32 m0, s47, 8192
    ds_read_b64_tr_b16 a[112:113], v16 offset:57344
    buffer_load_dwordx4 v8, s[16:19], s9 offen lds
    ds_read_b64_tr_b16 a[114:115], v16 offset:58368
    ds_read_b64_tr_b16 a[116:117], v17 offset:57344
    ds_read_b64_tr_b16 a[118:119], v17 offset:58368
    buffer_load_dwordx4 v9, s[16:19], s9 offen offset:1024 lds
    ds_read_b64_tr_b16 a[120:121], v16 offset:59392
    ds_read_b64_tr_b16 a[122:123], v16 offset:60416
    ds_read_b64_tr_b16 a[124:125], v17 offset:59392
    buffer_load_dwordx4 v10, s[16:19], s9 offen offset:2048 lds
    ds_read_b64_tr_b16 a[126:127], v17 offset:60416
    ds_read_b64_tr_b16 a[128:129], v18 offset:0
    ds_read_b64_tr_b16 a[130:131], v18 offset:1024
    buffer_load_dwordx4 v11, s[16:19], s9 offen offset:3072 lds
    ds_read_b64_tr_b16 a[132:133], v19 offset:0
    ds_read_b64_tr_b16 a[134:135], v19 offset:1024
    ds_read_b64_tr_b16 a[136:137], v18 offset:2048
    buffer_load_ubyte v32, v31, s[32:35], 0 offen sc1
    s_waitcnt vmcnt(9)
    ds_read_b128 v[168:171], v34 offset:0
    ds_read_b128 v[172:175], v35 offset:0
    ds_read_b128 v[176:179], v36 offset:0
    ds_read_b128 v[180:183], v37 offset:0
    s_mov_b32 m0, s46
    ds_read_b64_tr_b16 a[138:139], v18 offset:3072
    ds_read_b64_tr_b16 a[140:141], v19 offset:2048
    ds_read_b64_tr_b16 a[142:143], v19 offset:3072
    buffer_load_dwordx4 v4, s[20:23], s58 offen lds
    ds_read_b64_tr_b16 a[144:145], v18 offset:8192
    ds_read_b64_tr_b16 a[146:147], v18 offset:9216
    ds_read_b64_tr_b16 a[148:149], v19 offset:8192
    s_waitcnt lgkmcnt(8)
    v_mfma_f32_32x32x16_bf16 v[216:231], a[112:115], v[168:171], v[216:231]
    buffer_load_dwordx4 v5, s[20:23], s58 offen offset:1024 lds
    ds_read_b64_tr_b16 a[150:151], v19 offset:9216
    ds_read_b64_tr_b16 a[152:153], v18 offset:10240
    ds_read_b64_tr_b16 a[154:155], v18 offset:11264
    v_mfma_f32_32x32x16_bf16 v[232:247], a[116:119], v[168:171], v[232:247]
    v_lshlrev_b32 v106, 16, v69
    v_and_b32 v107, 0xffff0000, v69
    ds_read_b64_tr_b16 a[156:157], v19 offset:10240
    ds_read_b64_tr_b16 a[158:159], v19 offset:11264
    ds_read_b64_tr_b16 a[160:161], v18 offset:16384
    v_mfma_f32_32x32x16_bf16 v[216:231], a[120:123], v[172:175], v[216:231]
    v_lshlrev_b32 v108, 16, v70
    v_and_b32 v109, 0xffff0000, v70
    s_add_u32 m0, s46, 8192
    ds_read_b64_tr_b16 a[162:163], v18 offset:17408
    ds_read_b64_tr_b16 a[164:165], v19 offset:16384
    ds_read_b64_tr_b16 a[166:167], v19 offset:17408
    v_mfma_f32_32x32x16_bf16 v[232:247], a[124:127], v[172:175], v[232:247]
    buffer_load_dwordx4 v4, s[20:23], s59 offen lds
    ds_read_b64_tr_b16 a[168:169], v18 offset:18432
    ds_read_b64_tr_b16 a[170:171], v18 offset:19456
    ds_read_b64_tr_b16 a[172:173], v19 offset:18432
    s_waitcnt lgkmcnt(14)
    v_mfma_f32_32x32x16_bf16 v[216:231], a[128:131], v[176:179], v[216:231]
    buffer_load_dwordx4 v5, s[20:23], s59 offen offset:1024 lds
    ds_read_b64_tr_b16 a[174:175], v19 offset:19456
    ds_read_b64_tr_b16 a[176:177], v18 offset:24576
    ds_read_b64_tr_b16 a[178:179], v18 offset:25600
    v_mfma_f32_32x32x16_bf16 v[232:247], a[132:135], v[176:179], v[232:247]
    v_lshlrev_b32 v110, 16, v71
    v_and_b32 v111, 0xffff0000, v71
    ds_read_b64_tr_b16 a[180:181], v19 offset:24576
    ds_read_b64_tr_b16 a[182:183], v19 offset:25600
    ds_read_b64_tr_b16 a[184:185], v18 offset:26624
    v_mfma_f32_32x32x16_bf16 v[216:231], a[136:139], v[180:183], v[216:231]
    v_readlane_b32 s71, v62, 1
    v_readlane_b32 s72, v62, 2
    s_waitcnt vmcnt(9)
    ds_read_b128 v[184:187], v34 offset:4096
    ds_read_b128 v[188:191], v35 offset:4096
    ds_read_b128 v[192:195], v36 offset:4096
    ds_read_b128 v[196:199], v37 offset:4096
    s_add_u32 m0, s46, 16384
    ds_read_b64_tr_b16 a[186:187], v18 offset:27648
    ds_read_b64_tr_b16 a[188:189], v19 offset:26624
    ds_read_b64_tr_b16 a[190:191], v19 offset:27648
    v_mfma_f32_32x32x16_bf16 v[232:247], a[140:143], v[180:183], v[232:247]
    buffer_load_dwordx4 v4, s[20:23], s60 offen lds
    ds_read_b64_tr_b16 a[192:193], v18 offset:32768
    ds_read_b64_tr_b16 a[194:195], v18 offset:33792
    ds_read_b64_tr_b16 a[196:197], v19 offset:32768
    s_waitcnt lgkmcnt(8)
    v_mfma_f32_32x32x16_bf16 v[216:231], a[144:147], v[184:187], v[216:231]
    buffer_load_dwordx4 v5, s[20:23], s60 offen offset:1024 lds
    ds_read_b64_tr_b16 a[198:199], v19 offset:33792
    ds_read_b64_tr_b16 a[200:201], v18 offset:34816
    ds_read_b64_tr_b16 a[202:203], v18 offset:35840
    v_mfma_f32_32x32x16_bf16 v[232:247], a[148:151], v[184:187], v[232:247]
    v_readlane_b32 s73, v62, 3
    v_readlane_b32 s74, v62, 4
    ds_read_b64_tr_b16 a[204:205], v19 offset:34816
    ds_read_b64_tr_b16 a[206:207], v19 offset:35840
    v_mfma_f32_32x32x16_bf16 v[216:231], a[152:155], v[188:191], v[216:231]
    v_readlane_b32 s75, v62, 5
    v_readlane_b32 s76, v62, 6
    v_mfma_f32_32x32x16_bf16 v[232:247], a[156:159], v[188:191], v[232:247]
    v_readlane_b32 s77, v62, 7
    v_readlane_b32 s78, v62, 8
    s_waitcnt lgkmcnt(11)
    v_mfma_f32_32x32x16_bf16 v[216:231], a[160:163], v[192:195], v[216:231]
    v_readlane_b32 s79, v62, 9
    v_readlane_b32 s80, v62, 10
    s_waitcnt vmcnt(7)
    ds_read_b128 v[200:203], v34 offset:8192
    ds_read_b128 v[204:207], v35 offset:8192
    ds_read_b128 v[208:211], v36 offset:8192
    ds_read_b128 v[212:215], v37 offset:8192
    v_mfma_f32_32x32x16_bf16 v[232:247], a[164:167], v[192:195], v[232:247]
    v_readlane_b32 s81, v62, 11
    v_readlane_b32 s82, v62, 12
    v_mfma_f32_32x32x16_bf16 v[216:231], a[168:171], v[196:199], v[216:231]
    v_mfma_f32_32x32x16_bf16 v[232:247], a[172:175], v[196:199], v[232:247]
    s_waitcnt lgkmcnt(2)
    v_mfma_f32_32x32x16_bf16 v[232:247], a[180:183], v[200:203], v[232:247]
    v_mfma_f32_32x32x16_bf16 v[232:247], a[188:191], v[204:207], v[232:247]
    s_waitcnt lgkmcnt(0)
    s_waitcnt vmcnt(6)
    v_cmp_ne_u32 vcc, s49, v32
    s_mov_b32 s44, 0
    s_cbranch_vccz L_EPI
L_ACK2:
    v_cmp_gt_u32 vcc, 0x80, v32
    s_mov_b32 s44, 1
    s_cbranch_vccz L_EPI
    s_cmp_eq_u32 s45, 0
    s_cbranch_scc1 L_EPI
    s_sub_u32 s45, s45, 1
    buffer_load_ubyte v32, v31, s[32:35], 0 offen sc1
    s_waitcnt vmcnt(0)
    v_cmp_ne_u32 vcc, s49, v32
    s_mov_b32 s44, 0
    s_cbranch_vccz L_EPI
    s_branch L_ACK2
L_TOP:
    buffer_load_dwordx4 v[120:123], v28, s[36:39], s71 offen offset:0 sc1
    ds_read_b64_tr_b16 a[48:49], v16 offset:24576
    ds_read_b64_tr_b16 a[50:51], v16 offset:25600
    ds_read_b64_tr_b16 a[52:53], v17 offset:24576
    ds_read_b64_tr_b16 a[54:55], v17 offset:25600
    ds_read_b64_tr_b16 a[56:57], v16 offset:26624
    ds_read_b64_tr_b16 a[58:59], v16 offset:27648
    s_waitcnt lgkmcnt(14)
    v_mfma_f32_32x32x16_bf16 v[216:231], a[0:3], v[112:115], v[216:231]
    buffer_load_dwordx4 v[124:127], v28, s[36:39], s71 offen offset:1024 sc1
    ds_read_b64_tr_b16 a[60:61], v17 offset:26624
    ds_read_b64_tr_b16 a[62:63], v17 offset:27648
    ds_read_b64_tr_b16 a[64:65], v16 offset:32768
    ds_read_b64_tr_b16 a[66:67], v16 offset:33792
    ds_read_b64_tr_b16 a[68:69], v17 offset:32768
    ds_read_b64_tr_b16 a[70:71], v17 offset:33792
    v_mfma_f32_32x32x16_bf16 v[232:247], a[4:7], v[112:115], 0
    buffer_load_dwordx4 v[128:131], v28, s[36:39], s72 offen offset:0 sc1
    ds_read_b64_tr_b16 a[72:73], v16 offset:34816
    ds_read_b64_tr_b16 a[74:75], v16 offset:35840
    ds_read_b64_tr_b16 a[76:77], v17 offset:34816
    ds_read_b64_tr_b16 a[78:79], v17 offset:35840
    ds_read_b64_tr_b16 a[80:81], v16 offset:40960
    ds_read_b64_tr_b16 a[82:83], v16 offset:41984
    v_mfma_f32_32x32x16_bf16 v[216:231], a[8:11], v[116:119], v[216:231]
    buffer_load_dwordx4 v[132:135], v28, s[36:39], s72 offen offset:1024 sc1
    ds_read_b64_tr_b16 a[84:85], v17 offset:40960
    ds_read_b64_tr_b16 a[86:87], v17 offset:41984
    ds_read_b64_tr_b16 a[88:89], v16 offset:43008
    ds_read_b64_tr_b16 a[90:91], v16 offset:44032
    ds_read_b64_tr_b16 a[92:93], v17 offset:43008
    ds_read_b64_tr_b16 a[94:95], v17 offset:44032
    buffer_load_dwordx4 v[136:139], v28, s[36:39], s73 offen offset:0 sc1
    ds_read_b64_tr_b16 a[96:97], v16 offset:49152
    ds_read_b64_tr_b16 a[98:99], v16 offset:50176
    ds_read_b64_tr_b16 a[100:101], v17 offset:49152
    ds_read_b64_tr_b16 a[102:103], v17 offset:50176
    ds_read_b64_tr_b16 a[104:105], v16 offset:51200
    ds_read_b64_tr_b16 a[106:107], v16 offset:52224
    buffer_load_dwordx4 v[140:143], v28, s[36:39], s73 offen offset:1024 sc1
    ds_read_b64_tr_b16 a[108:109], v17 offset:51200
    ds_read_b64_tr_b16 a[110:111], v17 offset:52224
    ds_read_b64_tr_b16 a[112:113], v16 offset:57344
    ds_read_b64_tr_b16 a[114:115], v16 offset:58368
    ds_read_b64_tr_b16 a[116:117], v17 offset:57344
    ds_read_b64_tr_b16 a[118:119], v17 offset:58368
    buffer_load_dwordx4 v[144:147], v28, s[36:39], s74 offen offset:0 sc1
    ds_read_b64_tr_b16 a[120:121], v16 offset:59392
    ds_read_b64_tr_b16 a[122:123], v16 offset:60416
    ds_read_b64_tr_b16 a[124:125], v17 offset:59392
    ds_read_b64_tr_b16 a[126:127], v17 offset:60416
    buffer_load_dwordx4 v[148:151], v28, s[36:39], s74 offen offset:1024 sc1
    s_waitcnt lgkmcnt(0)
    s_waitcnt vmcnt(6)
    v_max_u32 v33, v120, v124
    v_cmp_eq_u32 vcc, -1, v33
    s_barrier
    v_mfma_f32_32x32x16_bf16 v[232:247], a[12:15], v[116:119], v[232:247]
    s_cbranch_vccnz L_RT1
L_BK1:
    v_mfma_f32_32x32x16_bf16 v[216:231], a[16:19], v[120:123], v[216:231]
    buffer_load_dwordx4 v[152:155], v28, s[36:39], s75 offen offset:0 sc1
    ds_read_b64_tr_b16 a[128:129], v18 offset:0
    ds_read_b64_tr_b16 a[130:131], v18 offset:1024
    v_mfma_f32_32x32x16_bf16 v[232:247], a[20:23], v[120:123], v[232:247]
    buffer_load_dwordx4 v[156:159], v28, s[36:39], s75 offen offset:1024 sc1
    ds_read_b64_tr_b16 a[132:133], v19 offset:0
    ds_read_b64_tr_b16 a[134:135], v19 offset:1024
    v_mfma_f32_32x32x16_bf16 v[216:231], a[24:27], v[124:127], v[216:231]
    ds_read_b64_tr_b16 a[136:137], v18 offset:2048
    s_waitcnt vmcnt(6)
    v_max_u32 v33, v128, v132
    v_cmp_eq_u32 vcc, -1, v33
    v_mfma_f32_32x32x16_bf16 v[232:247], a[28:31], v[124:127], v[232:247]
    s_cbranch_vccnz L_RT2
L_BK2:
    v_mfma_f32_32x32x16_bf16 v[216:231], a[32:35], v[128:131], v[216:231]
    buffer_load_dwordx4 v[160:163], v28, s[36:39], s76 offen offset:0 sc1
    ds_read_b64_tr_b16 a[138:139], v18 offset:3072
    ds_read_b64_tr_b16 a[140:141], v19 offset:2048
    v_mfma_f32_32x32x16_bf16 v[232:247], a[36:39], v[128:131], v[232:247]
    buffer_load_dwordx4 v[164:167], v28, s[36:39], s76 offen offset:1024 sc1
    ds_read_b64_tr_b16 a[142:143], v19 offset:3072
    ds_read_b64_tr_b16 a[144:145], v18 offset:8192
    v_mfma_f32_32x32x16_bf16 v[216:231], a[40:43], v[132:135], v[216:231]
    ds_read_b64_tr_b16 a[146:147], v18 offset:9216
    s_waitcnt vmcnt(6)
    v_max_u32 v33, v136, v140
    v_cmp_eq_u32 vcc, -1, v33
    v_mfma_f32_32x32x16_bf16 v[232:247], a[44:47], v[132:135], v[232:247]
    s_cbranch_vccnz L_RT3
L_BK3:
    v_mfma_f32_32x32x16_bf16 v[216:231], a[48:51], v[136:139], v[216:231]
    buffer_load_dwordx4 v[168:171], v28, s[36:39], s77 offen offset:0 sc1
    ds_read_b64_tr_b16 a[148:149], v19 offset:8192
    ds_read_b64_tr_b16 a[150:151], v19 offset:9216
    v_mfma_f32_32x32x16_bf16 v[232:247], a[52:55], v[136:139], v[232:247]
    buffer_load_dwordx4 v[172:175], v28, s[36:39], s77 offen offset:1024 sc1
    ds_read_b64_tr_b16 a[152:153], v18 offset:10240
    ds_read_b64_tr_b16 a[154:155], v18 offset:11264
    v_mfma_f32_32x32x16_bf16 v[216:231], a[56:59], v[140:143], v[216:231]
    ds_read_b64_tr_b16 a[156:157], v19 offset:10240
    s_waitcnt vmcnt(6)
    v_max_u32 v33, v144, v148
    v_cmp_eq_u32 vcc, -1, v33
    v_mfma_f32_32x32x16_bf16 v[232:247], a[60:63], v[140:143], v[232:247]
    s_cbranch_vccnz L_RT4
L_BK4:
    v_mfma_f32_32x32x16_bf16 v[216:231], a[64:67], v[144:147], v[216:231]
    buffer_load_dwordx4 v[176:179], v28, s[36:39], s78 offen offset:0 sc1
    ds_read_b64_tr_b16 a[158:159], v19 offset:11264
    ds_read_b64_tr_b16 a[160:161], v18 offset:16384
    v_mfma_f32_32x32x16_bf16 v[232:247], a[68:71], v[144:147], v[232:247]
    buffer_load_dwordx4 v[180:183], v28, s[36:39], s78 offen offset:1024 sc1
    ds_read_b64_tr_b16 a[162:163], v18 offset:17408
    ds_read_b64_tr_b16 a[164:165], v19 offset:16384
    v_mfma_f32_32x32x16_bf16 v[216:231], a[72:75], v[148:151], v[216:231]
    ds_read_b64_tr_b16 a[166:167], v19 offset:17408
    s_waitcnt vmcnt(6)
    v_max_u32 v33, v152, v156
    v_cmp_eq_u32 vcc, -1, v33
    v_mfma_f32_32x32x16_bf16 v[232:247], a[76:79], v[148:151], v[232:247]
    s_cbranch_vccnz L_RT5
L_BK5:
    v_mfma_f32_32x32x16_bf16 v[216:231], a[80:83], v[152:155], v[216:231]
    buffer_load_dwordx4 v[184:187], v28, s[36:39], s79 offen offset:0 sc1
    ds_read_b64_tr_b16 a[168:169], v18 offset:18432
    ds_read_b64_tr_b16 a[170:171], v18 offset:19456
    v_mfma_f32_32x32x16_bf16 v[232:247], a[84:87], v[152:155], v[232:247]
    buffer_load_dwordx4 v[188:191], v28, s[36:39], s79 offen offset:1024 sc1
    ds_read_b64_tr_b16 a[172:173], v19 offset:18432
    ds_read_b64_tr_b16 a[174:175], v19 offset:19456
    v_mfma_f32_32x32x16_bf16 v[216:231], a[88:91], v[156:159], v[216:231]
    ds_read_b64_tr_b16 a[176:177], v18 offset:24576
    s_waitcnt vmcnt(6)
    v_max_u32 v33, v160, v164
    v_cmp_eq_u32 vcc, -1, v33
    v_mfma_f32_32x32x16_bf16 v[232:247], a[92:95], v[156:159], v[232:247]
    s_cbranch_vccnz L_RT6
L_BK6:
    v_mfma_f32_32x32x16_bf16 v[216:231], a[96:99], v[160:163], v[216:231]
    buffer_load_dwordx4 v[192:195], v28, s[36:39], s80 offen offset:0 sc1
    ds_read_b64_tr_b16 a[178:179], v18 offset:25600
    ds_read_b64_tr_b16 a[180:181], v19 offset:24576
    v_mfma_f32_32x32x16_bf16 v[232:247], a[100:103], v[160:163], v[232:247]
    buffer_load_dwordx4 v[196:199], v28, s[36:39], s80 offen offset:1024 sc1
    ds_read_b64_tr_b16 a[182:183], v19 offset:25600
    ds_read_b64_tr_b16 a[184:185], v18 offset:26624
    v_mfma_f32_32x32x16_bf16 v[216:231], a[104:107], v[164:167], v[216:231]
    ds_read_b64_tr_b16 a[186:187], v18 offset:27648
    s_waitcnt vmcnt(6)
    v_max_u32 v33, v168, v172
    v_cmp_eq_u32 vcc, -1, v33
    v_mfma_f32_32x32x16_bf16 v[232:247], a[108:111], v[164:167], v[232:247]
    s_cbranch_vccnz L_RT7
L_BK7:
    v_mfma_f32_32x32x16_bf16 v[216:231], a[112:115], v[168:171], v[216:231]
    buffer_load_dwordx4 v[200:203], v28, s[36:39], s81 offen offset:0 sc1
    ds_read_b64_tr_b16 a[188:189], v19 offset:26624
    ds_read_b64_tr_b16 a[190:191], v19 offset:27648
    v_mfma_f32_32x32x16_bf16 v[232:247], a[116:119], v[168:171], v[232:247]
    buffer_load_dwordx4 v[204:207], v28, s[36:39], s81 offen offset:1024 sc1
    ds_read_b64_tr_b16 a[192:193], v18 offset:32768
    ds_read_b64_tr_b16 a[194:195], v18 offset:33792
    v_mfma_f32_32x32x16_bf16 v[216:231], a[120:123], v[172:175], v[216:231]
    ds_read_b64_tr_b16 a[196:197], v19 offset:32768
    s_waitcnt vmcnt(6)
    v_max_u32 v33, v176, v180
    v_cmp_eq_u32 vcc, -1, v33
    v_mfma_f32_32x32x16_bf16 v[232:247], a[124:127], v[172:175], v[232:247]
    s_cbranch_vccnz L_RT8
L_BK8:
    s_waitcnt lgkmcnt(14)
    v_mfma_f32_32x32x16_bf16 v[216:231], a[128:131], v[176:179], v[216:231]
    buffer_load_dwordx4 v[208:211], v28, s[36:39], s82 offen offset:0 sc1
    ds_read_b64_tr_b16 a[198:199], v19 offset:33792
    ds_read_b64_tr_b16 a[200:201], v18 offset:34816
    v_mfma_f32_32x32x16_bf16 v[232:247], a[132:135], v[176:179], v[232:247]
    buffer_load_dwordx4 v[212:215], v28, s[36:39], s82 offen offset:1024 sc1
    ds_read_b64_tr_b16 a[202:203], v18 offset:35840
    ds_read_b64_tr_b16 a[204:205], v19 offset:34816
    v_mfma_f32_32x32x16_bf16 v[216:231], a[136:139], v[180:183], v[216:231]
    ds_read_b64_tr_b16 a[206:207], v19 offset:35840
    s_waitcnt vmcnt(6)
    v_max_u32 v33, v184, v188
    v_cmp_eq_u32 vcc, -1, v33
    v_mfma_f32_32x32x16_bf16 v[232:247], a[140:143], v[180:183], v[232:247]
    s_cbranch_vccnz L_RT9
L_BK9:
    v_mfma_f32_32x32x16_bf16 v[216:231], a[144:147], v[184:187], v[216:231]
    s_mov_b32 m0, s46
    s_nop 0
    buffer_load_dwordx4 v4, s[20:23], s58 offen lds
    v_mfma_f32_32x32x16_bf16 v[232:247], a[148:151], v[184:187], v[232:247]
    buffer_load_dwordx4 v5, s[20:23], s58 offen offset:1024 lds
    v_mfma_f32_32x32x16_bf16 v[216:231], a[152:155], v[188:191], v[216:231]
    s_waitcnt vmcnt(6)
    v_max_u32 v33, v192, v196
    v_cmp_eq_u32 vcc, -1, v33
    v_mfma_f32_32x32x16_bf16 v[232:247], a[156:159], v[188:191], v[232:247]
    s_cbranch_vccnz L_RT10
L_BK10:
    v_mfma_f32_32x32x16_bf16 v[216:231], a[160:163], v[192:195], v[216:231]
    s_add_u32 m0, s46, 8192
    s_nop 0
    buffer_load_dwordx4 v4, s[20:23], s59 offen lds
    v_mfma_f32_32x32x16_bf16 v[232:247], a[164:167], v[192:195], v[232:247]
    buffer_load_dwordx4 v5, s[20:23], s59 offen offset:1024 lds
    s_waitcnt lgkmcnt(14)
    v_mfma_f32_32x32x16_bf16 v[216:231], a[168:171], v[196:199], v[216:231]
    s_waitcnt vmcnt(6)
    v_max_u32 v33, v200, v204
    v_cmp_eq_u32 vcc, -1, v33
    v_mfma_f32_32x32x16_bf16 v[232:247], a[172:175], v[196:199], v[232:247]
    s_cbranch_vccnz L_RT11
L_BK11:
    s_waitcnt lgkmcnt(12)
    v_mfma_f32_32x32x16_bf16 v[232:247], a[180:183], v[200:203], v[232:247]
    s_add_u32 m0, s46, 16384
    s_nop 0
    buffer_load_dwordx4 v4, s[20:23], s60 offen lds
    buffer_load_dwordx4 v5, s[20:23], s60 offen offset:1024 lds
    s_waitcnt vmcnt(6)
    v_max_u32 v33, v208, v212
    v_cmp_eq_u32 vcc, -1, v33
    s_waitcnt lgkmcnt(8)
    v_mfma_f32_32x32x16_bf16 v[232:247], a[188:191], v[204:207], v[232:247]
    s_cbranch_vccnz L_RT12
L_BK12:
    s_waitcnt lgkmcnt(0)
    v_add_u32 v28, 1703936, v28
L_EPI:
    v_mfma_f32_32x32x16_bf16 v[232:247], a[196:199], v[208:211], v[232:247]
    s_add_u32 m0, s46, 24576
    v_mov_b32 v48, v56
    buffer_load_dwordx4 v4, s[20:23], s61 offen lds
    v_mfma_f32_32x32x16_bf16 v[232:247], a[204:207], v[212:215], v[232:247]
    buffer_load_dwordx4 v5, s[20:23], s61 offen offset:1024 lds
    s_add_u32 m0, s46, 32768
    v_mov_b32 v56, v57
    buffer_load_dwordx4 v4, s[20:23], s62 offen lds
    v_mov_b32 v57, v58
    v_mov_b32 v58, v59
    v_mfma_f32_32x32x16_bf16 v[216:231], a[176:179], v[200:203], v[216:231]
    v_mov_b32 v59, v60
    s_add_u32 s43, s43, 1
    s_nop 2
    ds_write_b128 v20, v[232:235] offset:0
    v_mfma_f32_32x32x16_bf16 v[216:231], a[184:187], v[204:207], v[216:231]
    ds_write_b128 v20, v[236:239] offset:1024
    ds_write_b128 v20, v[240:243] offset:2048
    ds_write_b128 v20, v[244:247] offset:3072
    v_mfma_f32_32x32x16_bf16 v[216:231], a[192:195], v[208:211], v[216:231]
    buffer_load_dwordx4 v5, s[20:23], s62 offen offset:1024 lds
    v_mfma_f32_32x32x16_bf16 v[216:231], a[200:203], v[212:215], v[216:231]
    s_add_u32 m0, s46, 40960
    s_nop 0
    buffer_load_dwordx4 v4, s[20:23], s63 offen lds
    buffer_load_dwordx4 v5, s[20:23], s63 offen offset:1024 lds
    s_waitcnt lgkmcnt(0)
    s_barrier
    ds_read_b128 v[64:67], v21 offset:0
    ds_read_b128 v[68:71], v21 offset:1024
    ds_read_b128 v[72:75], v21 offset:2048
    ds_read_b128 v[76:79], v21 offset:3072
    s_add_u32 m0, s46, 49152
    s_nop 0
    buffer_load_dwordx4 v4, s[20:23], s64 offen lds
    buffer_load_dwordx4 v5, s[20:23], s64 offen offset:1024 lds
    v_fmac_f32 v96, v80, v216
    v_fmac_f32 v97, v81, v217
    v_fmac_f32 v98, v82, v218
    v_fmac_f32 v99, v83, v219
    v_fmac_f32 v100, v84, v220
    v_fmac_f32 v101, v85, v221
    s_add_u32 m0, s46, 57344
    v_fmac_f32 v102, v86, v222
    buffer_load_dwordx4 v4, s[20:23], s65 offen lds
    v_fmac_f32 v103, v87, v223
    v_fmac_f32 v104, v88, v224
    v_fmac_f32 v105, v89, v225
    v_fmac_f32 v106, v90, v226
    v_fmac_f32 v107, v91, v227
    v_fmac_f32 v108, v92, v228
    buffer_load_dwordx4 v5, s[20:23], s65 offen offset:1024 lds
    s_cmp_lg_u32 s44, 0
    v_fmac_f32 v109, v93, v229
    v_fmac_f32 v110, v94, v230
    v_fmac_f32 v111, v95, v231
    s_cbranch_scc1 L_ALT
    s_waitcnt lgkmcnt(2)
    v_fmac_f32 v96, v80, v64
    v_fmac_f32 v97, v81, v65
    v_fmac_f32 v98, v82, v66
    v_fmac_f32 v99, v83, v67
    v_fmac_f32 v100, v84, v68
    v_fmac_f32 v101, v85, v69
    v_fmac_f32 v102, v86, v70
    v_fmac_f32 v103, v87, v71
    v_cvt_pk_bf16_f32 v112, v96, v97
    v_cvt_pk_bf16_f32 v113, v98, v99
    v_cvt_pk_bf16_f32 v114, v100, v101
    v_cvt_pk_bf16_f32 v115, v102, v103
    v_min_u32 v112, -2, v112
    buffer_store_dwordx4 v[112:115], v28, s[36:39], s48 offen
    s_waitcnt lgkmcnt(0)
    v_fmac_f32 v104, v88, v72
    v_fmac_f32 v105, v89, v73
    v_fmac_f32 v106, v90, v74
    v_fmac_f32 v107, v91, v75
    v_fmac_f32 v108, v92, v76
    v_fmac_f32 v109, v93, v77
    v_fmac_f32 v110, v94, v78
    v_fmac_f32 v111, v95, v79
    v_cvt_pk_bf16_f32 v116, v104, v105
    v_cvt_pk_bf16_f32 v117, v106, v107
    v_cvt_pk_bf16_f32 v118, v108, v109
    v_cvt_pk_bf16_f32 v119, v110, v111
    v_min_u32 v116, -2, v116
    buffer_store_dwordx4 v[116:119], v28, s[36:39], s48 offen offset:1024
    buffer_store_dwordx4 v[24:27], v28, s[36:39], s50 offen
    buffer_store_dwordx4 v[24:27], v28, s[36:39], s50 offen offset:1024
L_POST:
    s_add_u32 m0, s46, 65536
    v_mfma_f32_32x32x16_bf16 v[216:231], v[48:51], v[52:55], 0
    buffer_load_dwordx4 v4, s[20:23], s66 offen lds
    buffer_load_dwordx4 v5, s[20:23], s66 offen offset:1024 lds
    s_add_u32 m0, s46, 73728
    s_cmp_eq_u32 s43, 5
    s_cselect_b32 s44, 2, s44
    buffer_load_dwordx4 v4, s[20:23], s67 offen lds
    buffer_load_dwordx4 v5, s[20:23], s67 offen offset:1024 lds
    s_add_u32 m0, s46, 81920
    s_nop 0
    buffer_load_dwordx4 v4, s[20:23], s68 offen lds
    buffer_load_dwordx4 v5, s[20:23], s68 offen offset:1024 lds
    s_waitcnt vmcnt(10)
    s_barrier
    s_add_u32 m0, s46, 90112
    ds_read_b64_tr_b16 a[0:1], v16 offset:0
    ds_read_b64_tr_b16 a[2:3], v16 offset:1024
    ds_read_b64_tr_b16 a[4:5], v17 offset:0
    ds_read_b64_tr_b16 a[6:7], v17 offset:1024
    ds_read_b64_tr_b16 a[8:9], v16 offset:2048
    ds_read_b64_tr_b16 a[10:11], v16 offset:3072
    buffer_load_dwordx4 v4, s[20:23], s69 offen lds
    ds_read_b64_tr_b16 a[12:13], v17 offset:2048
    ds_read_b64_tr_b16 a[14:15], v17 offset:3072
    ds_read_b64_tr_b16 a[16:17], v16 offset:8192
    ds_read_b64_tr_b16 a[18:19], v16 offset:9216
    ds_read_b64_tr_b16 a[20:21], v17 offset:8192
    ds_read_b64_tr_b16 a[22:23], v17 offset:9216
    buffer_load_dwordx4 v5, s[20:23], s69 offen offset:1024 lds
    s_add_u32 m0, s46, 98304
    ds_read_b64_tr_b16 a[24:25], v16 offset:10240
    ds_read_b64_tr_b16 a[26:27], v16 offset:11264
    ds_read_b64_tr_b16 a[28:29], v17 offset:10240
    ds_read_b64_tr_b16 a[30:31], v17 offset:11264
    ds_read_b64_tr_b16 a[32:33], v16 offset:16384
    ds_read_b64_tr_b16 a[34:35], v16 offset:17408
    buffer_load_dwordx4 v4, s[20:23], s70 offen lds
    ds_read_b64_tr_b16 a[36:37], v17 offset:16384
    ds_read_b64_tr_b16 a[38:39], v17 offset:17408
    ds_read_b64_tr_b16 a[40:41], v16 offset:18432
    ds_read_b64_tr_b16 a[42:43], v16 offset:19456
    ds_read_b64_tr_b16 a[44:45], v17 offset:18432
    ds_read_b64_tr_b16 a[46:47], v17 offset:19456
    buffer_load_dwordx4 v5, s[20:23], s70 offen offset:1024 lds
    v_add_u32 v4, 1384448, v4
    v_add_u32 v5, 1384448, v5
    s_branch L_TOP
L_ALT:
    s_cmp_eq_u32 s44, 2
    s_cbranch_scc1 L_LAST
    s_waitcnt lgkmcnt(2)
    v_fmac_f32 v96, v80, v64
    v_fmac_f32 v97, v81, v65
    v_fmac_f32 v98, v82, v66
    v_fmac_f32 v99, v83, v67
    v_fmac_f32 v100, v84, v68
    v_fmac_f32 v101, v85, v69
    v_fmac_f32 v102, v86, v70
    v_fmac_f32 v103, v87, v71
    v_cvt_pk_bf16_f32 v112, v96, v97
    v_cvt_pk_bf16_f32 v113, v98, v99
    v_cvt_pk_bf16_f32 v114, v100, v101
    v_cvt_pk_bf16_f32 v115, v102, v103
    v_min_u32 v112, -2, v112
    buffer_store_dwordx4 v[112:115], v28, s[36:39], s48 offen sc1
    s_waitcnt lgkmcnt(0)
    v_fmac_f32 v104, v88, v72
    v_fmac_f32 v105, v89, v73
    v_fmac_f32 v106, v90, v74
    v_fmac_f32 v107, v91, v75
    v_fmac_f32 v108, v92, v76
    v_fmac_f32 v109, v93, v77
    v_fmac_f32 v110, v94, v78
    v_fmac_f32 v111, v95, v79
    v_cvt_pk_bf16_f32 v116, v104, v105
    v_cvt_pk_bf16_f32 v117, v106, v107
    v_cvt_pk_bf16_f32 v118, v108, v109
    v_cvt_pk_bf16_f32 v119, v110, v111
    v_min_u32 v116, -2, v116
    buffer_store_dwordx4 v[116:119], v28, s[36:39], s48 offen offset:1024 sc1
    buffer_store_dwordx4 v[24:27], v28, s[36:39], s50 offen sc1
    buffer_store_dwordx4 v[24:27], v28, s[36:39], s50 offen offset:1024 sc1
    s_branch L_POST
L_LAST:
    s_waitcnt lgkmcnt(2)
    v_fmac_f32 v96, v80, v64
    v_fmac_f32 v97, v81, v65
    v_fmac_f32 v98, v82, v66
    v_fmac_f32 v99, v83, v67
    v_fmac_f32 v100, v84, v68
    v_fmac_f32 v101, v85, v69
    v_fmac_f32 v102, v86, v70
    v_fmac_f32 v103, v87, v71
    v_cvt_pk_bf16_f32 v112, v96, v97
    v_cvt_pk_bf16_f32 v113, v98, v99
    v_cvt_pk_bf16_f32 v114, v100, v101
    v_cvt_pk_bf16_f32 v115, v102, v103
    s_nop 0
    v_permlane32_swap_b32 v112, v114
    v_permlane32_swap_b32 v113, v115
    buffer_store_dwordx4 v[112:115], v30, s[28:31], 0 offen offset:0
    s_waitcnt lgkmcnt(0)
    v_fmac_f32 v104, v88, v72
    v_fmac_f32 v105, v89, v73
    v_fmac_f32 v106, v90, v74
    v_fmac_f32 v107, v91, v75
    v_fmac_f32 v108, v92, v76
    v_fmac_f32 v109, v93, v77
    v_fmac_f32 v110, v94, v78
    v_fmac_f32 v111, v95, v79
    v_cvt_pk_bf16_f32 v116, v104, v105
    v_cvt_pk_bf16_f32 v117, v106, v107
    v_cvt_pk_bf16_f32 v118, v108, v109
    v_cvt_pk_bf16_f32 v119, v110, v111
    s_nop 0
    v_permlane32_swap_b32 v116, v118
    v_permlane32_swap_b32 v117, v119
    buffer_store_dwordx4 v[116:119], v30, s[28:31], 0 offen offset:32
    s_waitcnt vmcnt(0)
L_EXIT:
    s_endpgm
L_RT1:
    s_cmp_eq_u32 s45, 0
    s_cbranch_scc1 L_BK1
    s_sub_u32 s45, s45, 1
    buffer_load_dwordx4 v[120:123], v28, s[36:39], s71 offen sc1
    buffer_load_dwordx4 v[124:127], v28, s[36:39], s71 offen offset:1024 sc1
    s_waitcnt vmcnt(0)
    v_max_u32 v33, v120, v124
    v_cmp_eq_u32 vcc, -1, v33
    s_cbranch_vccnz L_RT1
    s_branch L_BK1
L_RT2:
    s_cmp_eq_u32 s45, 0
    s_cbranch_scc1 L_BK2
    s_sub_u32 s45, s45, 1
    buffer_load_dwordx4 v[128:131], v28, s[36:39], s72 offen sc1
    buffer_load_dwordx4 v[132:135], v28, s[36:39], s72 offen offset:1024 sc1
    s_waitcnt vmcnt(0)
    v_max_u32 v33, v128, v132
    v_cmp_eq_u32 vcc, -1, v33
    s_cbranch_vccnz L_RT2
    s_branch L_BK2
L_RT3:
    s_cmp_eq_u32 s45, 0
    s_cbranch_scc1 L_BK3
    s_sub_u32 s45, s45, 1
    buffer_load_dwordx4 v[136:139], v28, s[36:39], s73 offen sc1
    buffer_load_dwordx4 v[140:143], v28, s[36:39], s73 offen offset:1024 sc1
    s_waitcnt vmcnt(0)
    v_max_u32 v33, v136, v140
    v_cmp_eq_u32 vcc, -1, v33
    s_cbranch_vccnz L_RT3
    s_branch L_BK3
L_RT4:
    s_cmp_eq_u32 s45, 0
    s_cbranch_scc1 L_BK4
    s_sub_u32 s45, s45, 1
    buffer_load_dwordx4 v[144:147], v28, s[36:39], s74 offen sc1
    buffer_load_dwordx4 v[148:151], v28, s[36:39], s74 offen offset:1024 sc1
    s_waitcnt vmcnt(0)
    v_max_u32 v33, v144, v148
    v_cmp_eq_u32 vcc, -1, v33
    s_cbranch_vccnz L_RT4
    s_branch L_BK4
L_RT5:
    s_cmp_eq_u32 s45, 0
    s_cbranch_scc1 L_BK5
    s_sub_u32 s45, s45, 1
    buffer_load_dwordx4 v[152:155], v28, s[36:39], s75 offen sc1
    buffer_load_dwordx4 v[156:159], v28, s[36:39], s75 offen offset:1024 sc1
    s_waitcnt vmcnt(0)
    v_max_u32 v33, v152, v156
    v_cmp_eq_u32 vcc, -1, v33
    s_cbranch_vccnz L_RT5
    s_branch L_BK5
L_RT6:
    s_cmp_eq_u32 s45, 0
    s_cbranch_scc1 L_BK6
    s_sub_u32 s45, s45, 1
    buffer_load_dwordx4 v[160:163], v28, s[36:39], s76 offen sc1
    buffer_load_dwordx4 v[164:167], v28, s[36:39], s76 offen offset:1024 sc1
    s_waitcnt vmcnt(0)
    v_max_u32 v33, v160, v164
    v_cmp_eq_u32 vcc, -1, v33
    s_cbranch_vccnz L_RT6
    s_branch L_BK6
L_RT7:
    s_cmp_eq_u32 s45, 0
    s_cbranch_scc1 L_BK7
    s_sub_u32 s45, s45, 1
    buffer_load_dwordx4 v[168:171], v28, s[36:39], s77 offen sc1
    buffer_load_dwordx4 v[172:175], v28, s[36:39], s77 offen offset:1024 sc1
    s_waitcnt vmcnt(0)
    v_max_u32 v33, v168, v172
    v_cmp_eq_u32 vcc, -1, v33
    s_cbranch_vccnz L_RT7
    s_branch L_BK7
L_RT8:
    s_cmp_eq_u32 s45, 0
    s_cbranch_scc1 L_BK8
    s_sub_u32 s45, s45, 1
    buffer_load_dwordx4 v[176:179], v28, s[36:39], s78 offen sc1
    buffer_load_dwordx4 v[180:183], v28, s[36:39], s78 offen offset:1024 sc1
    s_waitcnt vmcnt(0)
    v_max_u32 v33, v176, v180
    v_cmp_eq_u32 vcc, -1, v33
    s_cbranch_vccnz L_RT8
    s_branch L_BK8
L_RT9:
    s_cmp_eq_u32 s45, 0
    s_cbranch_scc1 L_BK9
    s_sub_u32 s45, s45, 1
    buffer_load_dwordx4 v[184:187], v28, s[36:39], s79 offen sc1
    buffer_load_dwordx4 v[188:191], v28, s[36:39], s79 offen offset:1024 sc1
    s_waitcnt vmcnt(0)
    v_max_u32 v33, v184, v188
    v_cmp_eq_u32 vcc, -1, v33
    s_cbranch_vccnz L_RT9
    s_branch L_BK9
L_RT10:
    s_cmp_eq_u32 s45, 0
    s_cbranch_scc1 L_BK10
    s_sub_u32 s45, s45, 1
    buffer_load_dwordx4 v[192:195], v28, s[36:39], s80 offen sc1
    buffer_load_dwordx4 v[196:199], v28, s[36:39], s80 offen offset:1024 sc1
    s_waitcnt vmcnt(0)
    v_max_u32 v33, v192, v196
    v_cmp_eq_u32 vcc, -1, v33
    s_cbranch_vccnz L_RT10
    s_branch L_BK10
L_RT11:
    s_cmp_eq_u32 s45, 0
    s_cbranch_scc1 L_BK11
    s_sub_u32 s45, s45, 1
    buffer_load_dwordx4 v[200:203], v28, s[36:39], s81 offen sc1
    buffer_load_dwordx4 v[204:207], v28, s[36:39], s81 offen offset:1024 sc1
    s_waitcnt vmcnt(0)
    v_max_u32 v33, v200, v204
    v_cmp_eq_u32 vcc, -1, v33
    s_cbranch_vccnz L_RT11
    s_branch L_BK11
L_RT12:
    s_cmp_eq_u32 s45, 0
    s_cbranch_scc1 L_BK12
    s_sub_u32 s45, s45, 1
    buffer_load_dwordx4 v[208:211], v28, s[36:39], s82 offen sc1
    buffer_load_dwordx4 v[212:215], v28, s[36:39], s82 offen offset:1024 sc1
    s_waitcnt vmcnt(0)
    v_max_u32 v33, v208, v212
    v_cmp_eq_u32 vcc, -1, v33
    s_cbranch_vccnz L_RT12
    s_branch L_BK12
L_HELP:
    s_sub_u32 s3, s3, 26
    s_lshl_b32 s3, s3, 2
    s_add_u32 s3, s3, s42
    v_mul_u32_u24 v1, 1664, v0
    v_lshlrev_b32 v2, 7, v0
    s_cmp_ge_u32 s3, 13
    s_cselect_b32 s4, 13, 0
    s_cselect_b32 s7, 4, 1
    s_sub_u32 s4, s3, s4
    s_lshl_b32 s6, s15, 2
    s_or_b32 s6, s6, 0x40000
    s_bfe_u32 s6, 0x02102102, s6
    s_add_u32 s7, s7, s6
    s_add_u32 s7, s7, s4
    s_sub_u32 s6, s7, 13
    s_min_u32 s7, s7, s6
    s_mul_i32 s7, s7, 106496
    s_lshl_b32 s4, s4, 7
    s_add_u32 s4, s4, s7
    s_lshl_b32 s5, s3, 3
    s_add_u32 s5, s5, s15
    s_lshl_b32 s5, s5, 13
    s_add_u32 s5, s5, 1384448
    s_waitcnt lgkmcnt(0)
    buffer_load_dword v4, v1, s[20:23], s4 offen
    s_mov_b32 s38, 8519680
    s_mov_b32 s39, 0x00020000
    s_lshl_b32 s8, s15, 1
    s_cmp_ge_u32 s3, 12
    s_cselect_b32 s9, 12, 0
    s_addc_u32 s8, s8, 0
    s_sub_u32 s9, s3, s9
    s_mul_i32 s7, s9, 9
    s_min_u32 s7, s7, 95
    s_mul_i32 s6, s8, 104
    s_add_u32 s7, s7, s6
    s_lshl_b32 s7, s7, 10
    v_lshlrev_b32 v11, 4, v0
    v_mov_b32 v12, -1
    v_mov_b32 v13, -1
    v_mov_b32 v14, -1
    v_mov_b32 v15, -1
    buffer_store_dwordx4 v[12:15], v11, s[36:39], s7 offen offset:0 sc1
    buffer_store_dwordx4 v[12:15], v11, s[36:39], s7 offen offset:1024 sc1
    buffer_store_dwordx4 v[12:15], v11, s[36:39], s7 offen offset:2048 sc1
    s_add_u32 s7, s7, 3072
    buffer_store_dwordx4 v[12:15], v11, s[36:39], s7 offen offset:0 sc1
    buffer_store_dwordx4 v[12:15], v11, s[36:39], s7 offen offset:1024 sc1
    buffer_store_dwordx4 v[12:15], v11, s[36:39], s7 offen offset:2048 sc1
    s_add_u32 s7, s7, 3072
    buffer_store_dwordx4 v[12:15], v11, s[36:39], s7 offen offset:0 sc1
    buffer_store_dwordx4 v[12:15], v11, s[36:39], s7 offen offset:1024 sc1
    buffer_store_dwordx4 v[12:15], v11, s[36:39], s7 offen offset:2048 sc1
    s_mov_b32 s34, 256
    s_mov_b32 s35, 0x00020000
    s_lshl_b32 s8, s8, 4
    s_lshr_b32 s9, s9, 2
    s_add_u32 s8, s8, s9
    s_add_u32 s8, s8, 13
    s_lshl_b32 s9, s42, 8
    s_add_u32 s8, s8, s9
    v_lshl_add_u32 v16, v0, 8, s8
    s_getreg_b32 s7, hwreg(HW_REG_XCC_ID)
    s_and_b32 s7, s7, 15
    s_or_b32 s7, s7, 0x80
    v_mov_b32 v17, s7
    buffer_load_dword v4, v2, s[20:23], s5 offen
    s_add_u32 s6, s3, 16
    s_sub_u32 s7, s3, 8
    s_min_u32 s6, s6, s7
    v_min_u32 v5, 15, v0
    v_mul_u32_u24 v5, 8, v5
    v_mul_u32_u24 v6, 24, v0
    v_sub_u32 v5, v6, v5
    v_add_u32 v5, s6, v5
    v_mul_u32_u24 v6, 5042, v5
    v_lshrrev_b32 v6, 16, v6
    v_mul_u32_u24 v7, 13, v6
    v_sub_u32 v5, v5, v7
    v_mul_u32_u24 v7, 7282, v6
    v_lshrrev_b32 v7, 16, v7
    v_mul_u32_u24 v8, 9, v7
    v_sub_u32 v6, v6, v8
    v_lshlrev_b32 v6, 2, v6
    s_mov_b32 s8, 1750682160
    s_mov_b32 s9, 7
    v_lshrrev_b64 v[8:9], v6, s[8:9]
    v_and_b32 v8, 15, v8
    v_add_u32 v8, v8, v5
    v_subrev_u32 v9, 13, v8
    v_min_u32 v8, v8, v9
    v_add_u32 v7, 1, v7
    v_mul_u32_u24 v7, 13, v7
    v_add_u32 v8, v8, v7
    v_mul_u32_u24 v10, 106496, v8
    v_lshl_add_u32 v10, v5, 7, v10
    s_mov_b32 s6, 0
    s_waitcnt vmcnt(1)
    s_barrier
    buffer_store_byte v17, v16, s[32:35], 0 offen sc1
    s_cmp_ge_u32 s3, 8
    s_cbranch_scc1 L_HL2
    s_add_u32 s5, s5, 1572864
L_HC:
    s_waitcnt vmcnt(1)
    buffer_load_dword v4, v2, s[20:23], s5 offen
    s_add_u32 s5, s5, 524288
    s_cmp_lt_u32 s5, 8306688
    s_cbranch_scc1 L_HC
    s_mov_b32 s6, 15
L_HL2:
    v_readlane_b32 s4, v10, s6
    s_add_u32 s6, s6, 1
    s_cmp_lt_u32 s6, 30
    s_nop 1
    s_waitcnt vmcnt(1)
    buffer_load_dword v4, v1, s[20:23], s4 offen
    s_cbranch_scc1 L_HL2
    s_waitcnt vmcnt(0)
    s_endpgm
L_END:
.section .rodata,"a"
.p2align 6
.amdhsa_kernel standalone__cross_network_dcn__recsys_kernel
  .amdhsa_next_free_vgpr 512
  .amdhsa_next_free_sgpr 102
  .amdhsa_accum_offset 256
  .amdhsa_group_segment_fixed_size 0
  .amdhsa_kernarg_size 48
  .amdhsa_user_sgpr_count 2
  .amdhsa_user_sgpr_kernarg_segment_ptr 1
  .amdhsa_system_sgpr_workgroup_id_x 1
.end_amdhsa_kernel
```
